```python
import torch

def _softmax(x, axis=-1):
    return torch.softmax(x, dim=axis)
def _gelu(x):
    return torch.nn.functional.gelu(x, approximate="tanh")
def _silu(x):
    return torch.nn.functional.silu(x)
def _sigmoid(x):
    return torch.sigmoid(x)
def _layernorm(x, axis=-1, eps=1e-5):
    m = x.mean(dim=axis, keepdim=True)
    v = x.var(dim=axis, keepdim=True, unbiased=False)
    return (x - m) / torch.sqrt(v + eps)
def _scatter_add(tgt, idx, src, axis=0):
    return tgt.clone().index_add_(axis, idx, src)
def _segment_sum(src, seg, n):
    out = torch.zeros((n,) + src.shape[1:], dtype=src.dtype)
    return out.index_add_(0, seg, src)
def _pad(x, pw):
    flat = tuple(v for pair in reversed(pw) for v in pair)
    return torch.nn.functional.pad(x, flat)

kernel_name = 'standalone__channel_attn_eca__vision'

def setup_inputs():

    _w = (lambda a: (lambda t: t.to(torch.bfloat16) if t.is_floating_point() else t)(torch.as_tensor(a)))
    H = W = 512
    C = 96
    k = 1
    return {
        "x": _w((lambda *s: torch.randn(*s, dtype=torch.bfloat16) * 0.8)(1, H, W, C) + (lambda *s: torch.randn(*s, dtype=torch.bfloat16) * 0.8)(1, 1, 1, C) * 2.0),
        "w1d": _w((lambda *s: torch.randn(*s, dtype=torch.bfloat16) * 0.8)(k)),
    }

def reference(x, w1d):
    B, H, W, C = x.shape
    k = 1
    pad = k // 2
    g = torch.einsum("bhwc->bc", x) / (H * W)
    gp = _pad(g, ((0, 0), (pad, pad)))
    s = torch.zeros_like(g)
    for i in range(k):
        s = s + gp[:, i:i + C] * w1d[i]
    s = _sigmoid(s)
    return x * s[:, None, None, :]
```

```asm
; @launch grid=(256,1,1) block=(832,1,1) lds=27392
.amdgcn_target "amdgcn-amd-amdhsa--gfx950"
.text
.globl standalone__channel_attn_eca__vision_kernel
.p2align 8
.type standalone__channel_attn_eca__vision_kernel,@function
standalone__channel_attn_eca__vision_kernel:
    s_cmp_ge_u32 s2, 256
    s_cbranch_scc1 L_end
    s_load_dwordx4 s[4:7], s[0:1], 0
    s_load_dwordx4 s[8:11], s[0:1], 16
    s_load_dwordx2 s[12:13], s[0:1], 32
    v_lshrrev_b32 v2, 6, v0
    v_lshlrev_b32 v1, 4, v0
    v_readfirstlane_b32 s3, v2
    s_mul_i32 s14, s2, 12288
    s_mov_b32 s18, 50331648
    s_mov_b32 s19, 0x00020000
    s_mov_b32 s22, 50331648
    s_mov_b32 s23, 0x00020000
    s_waitcnt lgkmcnt(0)
    s_load_dword s38, s[12:13], 335872
    s_mov_b32 s16, s4
    s_and_b32 s17, s5, 0xffff
    s_cmp_eq_u32 s3, 12
    s_cbranch_scc1 L_ctrl
    s_lshr_b32 s31, s2, 1
    s_mul_i32 s31, s31, 24576
    s_add_u32 s31, s31, 47185920
    s_and_b32 s37, s2, 1
    s_cmp_lg_u32 s37, 0
    s_cbranch_scc1 L_nxl
    s_add_u32 s15, s31, 0
    buffer_load_dwordx4 v[84:87], v1, s[16:19], s15 offen nt
    s_add_u32 s15, s31, 12288
    buffer_load_dwordx4 v[96:99], v1, s[16:19], s15 offen nt
L_nxl:
    s_mov_b32 s15, s14
    buffer_load_dwordx4 v[24:27], v1, s[16:19], s15 offen nt
    s_add_u32 s15, s15, 3145728
    buffer_load_dwordx4 v[28:31], v1, s[16:19], s15 offen nt
    s_add_u32 s15, s15, 3145728
    buffer_load_dwordx4 v[32:35], v1, s[16:19], s15 offen nt
    s_add_u32 s15, s15, 3145728
    buffer_load_dwordx4 v[36:39], v1, s[16:19], s15 offen nt
    s_add_u32 s15, s15, 3145728
    buffer_load_dwordx4 v[40:43], v1, s[16:19], s15 offen nt
    s_add_u32 s15, s15, 3145728
    buffer_load_dwordx4 v[44:47], v1, s[16:19], s15 offen nt
    s_add_u32 s15, s15, 3145728
    buffer_load_dwordx4 v[48:51], v1, s[16:19], s15 offen nt
    s_add_u32 s15, s15, 3145728
    buffer_load_dwordx4 v[52:55], v1, s[16:19], s15 offen nt
    s_add_u32 s15, s15, 3145728
    buffer_load_dwordx4 v[56:59], v1, s[16:19], s15 offen nt
    s_add_u32 s15, s15, 3145728
    buffer_load_dwordx4 v[60:63], v1, s[16:19], s15 offen nt
    s_add_u32 s15, s15, 3145728
    buffer_load_dwordx4 v[64:67], v1, s[16:19], s15 offen nt
    s_add_u32 s15, s15, 3145728
    buffer_load_dwordx4 v[68:71], v1, s[16:19], s15 offen nt
    s_add_u32 s15, s15, 3145728
    buffer_load_dwordx4 v[72:75], v1, s[16:19], s15 offen nt
    s_add_u32 s15, s15, 3145728
    buffer_load_dwordx4 v[76:79], v1, s[16:19], s15 offen nt
    s_add_u32 s15, s15, 3145728
    buffer_load_dwordx4 v[80:83], v1, s[16:19], s15 offen nt
    s_mov_b32 s20, s8
    s_and_b32 s21, s9, 0xffff
    s_mov_b32 s24, s12
    s_and_b32 s25, s13, 0xffff
    s_mov_b32 s26, 336128
    s_mov_b32 s27, 0x00020000
    s_mov_b32 s28, 0xffff0000
    v_mul_u32_u24 v2, 43691, v0
    v_lshrrev_b32 v2, 19, v2
    v_mul_u32_u24 v3, 12, v2
    v_sub_u32 v3, v0, v3
    v_mul_u32_u24 v4, 208, v2
    v_lshl_add_u32 v4, v3, 4, v4
    v_lshlrev_b32 v5, 5, v3
    v_and_b32 v6, 63, v0
    v_lshrrev_b32 v7, 3, v6
    v_mul_u32_u24 v7, 208, v7
    v_bfe_u32 v16, v6, 2, 1
    v_mul_u32_u24 v16, 13376, v16
    v_add_u32 v7, v7, v16
    v_and_b32 v16, 3, v6
    v_lshl_add_u32 v7, v16, 2, v7
    s_lshl_b32 s29, s3, 4
    v_add_u32 v7, s29, v7
    v_and_b32 v16, 7, v6
    v_lshlrev_b32 v16, 3, v16
    s_lshl_b32 s29, s3, 14
    s_lshl_b32 s30, s2, 6
    s_add_u32 s29, s29, s30
    v_lshlrev_b32 v88, 4, v6
    v_add_u32 v6, s29, v16
    v_mov_b32 v8, 0
    v_mov_b32 v9, 0
    v_mov_b32 v10, 0
    v_mov_b32 v11, 0
    v_mov_b32 v12, 0
    v_mov_b32 v13, 0
    v_mov_b32 v14, 0
    v_mov_b32 v15, 0
    s_cmp_lg_u32 s37, 0
    s_cbranch_scc1 L_nxa
    s_waitcnt vmcnt(16)
    v_lshlrev_b32 v16, 16, v84
    v_and_b32 v17, s28, v84
    v_lshlrev_b32 v18, 16, v85
    v_and_b32 v19, s28, v85
    v_lshlrev_b32 v20, 16, v86
    v_and_b32 v21, s28, v86
    v_lshlrev_b32 v22, 16, v87
    v_and_b32 v23, s28, v87
    v_pk_add_f32 v[8:9], v[8:9], v[16:17]
    v_pk_add_f32 v[10:11], v[10:11], v[18:19]
    v_pk_add_f32 v[12:13], v[12:13], v[20:21]
    v_pk_add_f32 v[14:15], v[14:15], v[22:23]
    s_waitcnt vmcnt(15)
    v_lshlrev_b32 v16, 16, v96
    v_and_b32 v17, s28, v96
    v_lshlrev_b32 v18, 16, v97
    v_and_b32 v19, s28, v97
    v_lshlrev_b32 v20, 16, v98
    v_and_b32 v21, s28, v98
    v_lshlrev_b32 v22, 16, v99
    v_and_b32 v23, s28, v99
    v_pk_add_f32 v[8:9], v[8:9], v[16:17]
    v_pk_add_f32 v[10:11], v[10:11], v[18:19]
    v_pk_add_f32 v[12:13], v[12:13], v[20:21]
    v_pk_add_f32 v[14:15], v[14:15], v[22:23]
L_nxa:
    s_waitcnt vmcnt(14)
    v_lshlrev_b32 v16, 16, v24
    v_and_b32 v17, s28, v24
    v_lshlrev_b32 v18, 16, v25
    v_and_b32 v19, s28, v25
    v_lshlrev_b32 v20, 16, v26
    v_and_b32 v21, s28, v26
    v_lshlrev_b32 v22, 16, v27
    v_and_b32 v23, s28, v27
    v_pk_add_f32 v[8:9], v[8:9], v[16:17]
    v_pk_add_f32 v[10:11], v[10:11], v[18:19]
    v_pk_add_f32 v[12:13], v[12:13], v[20:21]
    v_pk_add_f32 v[14:15], v[14:15], v[22:23]
    s_waitcnt vmcnt(13)
    v_lshlrev_b32 v16, 16, v28
    v_and_b32 v17, s28, v28
    v_lshlrev_b32 v18, 16, v29
    v_and_b32 v19, s28, v29
    v_lshlrev_b32 v20, 16, v30
    v_and_b32 v21, s28, v30
    v_lshlrev_b32 v22, 16, v31
    v_and_b32 v23, s28, v31
    v_pk_add_f32 v[8:9], v[8:9], v[16:17]
    v_pk_add_f32 v[10:11], v[10:11], v[18:19]
    v_pk_add_f32 v[12:13], v[12:13], v[20:21]
    v_pk_add_f32 v[14:15], v[14:15], v[22:23]
    s_waitcnt vmcnt(12)
    v_lshlrev_b32 v16, 16, v32
    v_and_b32 v17, s28, v32
    v_lshlrev_b32 v18, 16, v33
    v_and_b32 v19, s28, v33
    v_lshlrev_b32 v20, 16, v34
    v_and_b32 v21, s28, v34
    v_lshlrev_b32 v22, 16, v35
    v_and_b32 v23, s28, v35
    v_pk_add_f32 v[8:9], v[8:9], v[16:17]
    v_pk_add_f32 v[10:11], v[10:11], v[18:19]
    v_pk_add_f32 v[12:13], v[12:13], v[20:21]
    v_pk_add_f32 v[14:15], v[14:15], v[22:23]
    s_waitcnt vmcnt(11)
    v_lshlrev_b32 v16, 16, v36
    v_and_b32 v17, s28, v36
    v_lshlrev_b32 v18, 16, v37
    v_and_b32 v19, s28, v37
    v_lshlrev_b32 v20, 16, v38
    v_and_b32 v21, s28, v38
    v_lshlrev_b32 v22, 16, v39
    v_and_b32 v23, s28, v39
    v_pk_add_f32 v[8:9], v[8:9], v[16:17]
    v_pk_add_f32 v[10:11], v[10:11], v[18:19]
    v_pk_add_f32 v[12:13], v[12:13], v[20:21]
    v_pk_add_f32 v[14:15], v[14:15], v[22:23]
    s_waitcnt vmcnt(10)
    v_lshlrev_b32 v16, 16, v40
    v_and_b32 v17, s28, v40
    v_lshlrev_b32 v18, 16, v41
    v_and_b32 v19, s28, v41
    v_lshlrev_b32 v20, 16, v42
    v_and_b32 v21, s28, v42
    v_lshlrev_b32 v22, 16, v43
    v_and_b32 v23, s28, v43
    v_pk_add_f32 v[8:9], v[8:9], v[16:17]
    v_pk_add_f32 v[10:11], v[10:11], v[18:19]
    v_pk_add_f32 v[12:13], v[12:13], v[20:21]
    v_pk_add_f32 v[14:15], v[14:15], v[22:23]
    s_waitcnt vmcnt(9)
    v_lshlrev_b32 v16, 16, v44
    v_and_b32 v17, s28, v44
    v_lshlrev_b32 v18, 16, v45
    v_and_b32 v19, s28, v45
    v_lshlrev_b32 v20, 16, v46
    v_and_b32 v21, s28, v46
    v_lshlrev_b32 v22, 16, v47
    v_and_b32 v23, s28, v47
    v_pk_add_f32 v[8:9], v[8:9], v[16:17]
    v_pk_add_f32 v[10:11], v[10:11], v[18:19]
    v_pk_add_f32 v[12:13], v[12:13], v[20:21]
    v_pk_add_f32 v[14:15], v[14:15], v[22:23]
    s_waitcnt vmcnt(8)
    v_lshlrev_b32 v16, 16, v48
    v_and_b32 v17, s28, v48
    v_lshlrev_b32 v18, 16, v49
    v_and_b32 v19, s28, v49
    v_lshlrev_b32 v20, 16, v50
    v_and_b32 v21, s28, v50
    v_lshlrev_b32 v22, 16, v51
    v_and_b32 v23, s28, v51
    v_pk_add_f32 v[8:9], v[8:9], v[16:17]
    v_pk_add_f32 v[10:11], v[10:11], v[18:19]
    v_pk_add_f32 v[12:13], v[12:13], v[20:21]
    v_pk_add_f32 v[14:15], v[14:15], v[22:23]
    s_waitcnt vmcnt(7)
    v_lshlrev_b32 v16, 16, v52
    v_and_b32 v17, s28, v52
    v_lshlrev_b32 v18, 16, v53
    v_and_b32 v19, s28, v53
    v_lshlrev_b32 v20, 16, v54
    v_and_b32 v21, s28, v54
    v_lshlrev_b32 v22, 16, v55
    v_and_b32 v23, s28, v55
    v_pk_add_f32 v[8:9], v[8:9], v[16:17]
    v_pk_add_f32 v[10:11], v[10:11], v[18:19]
    v_pk_add_f32 v[12:13], v[12:13], v[20:21]
    v_pk_add_f32 v[14:15], v[14:15], v[22:23]
    s_waitcnt vmcnt(6)
    v_lshlrev_b32 v16, 16, v56
    v_and_b32 v17, s28, v56
    v_lshlrev_b32 v18, 16, v57
    v_and_b32 v19, s28, v57
    v_lshlrev_b32 v20, 16, v58
    v_and_b32 v21, s28, v58
    v_lshlrev_b32 v22, 16, v59
    v_and_b32 v23, s28, v59
    v_pk_add_f32 v[8:9], v[8:9], v[16:17]
    v_pk_add_f32 v[10:11], v[10:11], v[18:19]
    v_pk_add_f32 v[12:13], v[12:13], v[20:21]
    v_pk_add_f32 v[14:15], v[14:15], v[22:23]
    s_waitcnt vmcnt(5)
    v_lshlrev_b32 v16, 16, v60
    v_and_b32 v17, s28, v60
    v_lshlrev_b32 v18, 16, v61
    v_and_b32 v19, s28, v61
    v_lshlrev_b32 v20, 16, v62
    v_and_b32 v21, s28, v62
    v_lshlrev_b32 v22, 16, v63
    v_and_b32 v23, s28, v63
    v_pk_add_f32 v[8:9], v[8:9], v[16:17]
    v_pk_add_f32 v[10:11], v[10:11], v[18:19]
    v_pk_add_f32 v[12:13], v[12:13], v[20:21]
    v_pk_add_f32 v[14:15], v[14:15], v[22:23]
    s_waitcnt vmcnt(4)
    v_lshlrev_b32 v16, 16, v64
    v_and_b32 v17, s28, v64
    v_lshlrev_b32 v18, 16, v65
    v_and_b32 v19, s28, v65
    v_lshlrev_b32 v20, 16, v66
    v_and_b32 v21, s28, v66
    v_lshlrev_b32 v22, 16, v67
    v_and_b32 v23, s28, v67
    v_pk_add_f32 v[8:9], v[8:9], v[16:17]
    v_pk_add_f32 v[10:11], v[10:11], v[18:19]
    v_pk_add_f32 v[12:13], v[12:13], v[20:21]
    v_pk_add_f32 v[14:15], v[14:15], v[22:23]
    s_waitcnt vmcnt(3)
    v_lshlrev_b32 v16, 16, v68
    v_and_b32 v17, s28, v68
    v_lshlrev_b32 v18, 16, v69
    v_and_b32 v19, s28, v69
    v_lshlrev_b32 v20, 16, v70
    v_and_b32 v21, s28, v70
    v_lshlrev_b32 v22, 16, v71
    v_and_b32 v23, s28, v71
    v_pk_add_f32 v[8:9], v[8:9], v[16:17]
    v_pk_add_f32 v[10:11], v[10:11], v[18:19]
    v_pk_add_f32 v[12:13], v[12:13], v[20:21]
    v_pk_add_f32 v[14:15], v[14:15], v[22:23]
    s_waitcnt vmcnt(2)
    v_lshlrev_b32 v16, 16, v72
    v_and_b32 v17, s28, v72
    v_lshlrev_b32 v18, 16, v73
    v_and_b32 v19, s28, v73
    v_lshlrev_b32 v20, 16, v74
    v_and_b32 v21, s28, v74
    v_lshlrev_b32 v22, 16, v75
    v_and_b32 v23, s28, v75
    v_pk_add_f32 v[8:9], v[8:9], v[16:17]
    v_pk_add_f32 v[10:11], v[10:11], v[18:19]
    v_pk_add_f32 v[12:13], v[12:13], v[20:21]
    v_pk_add_f32 v[14:15], v[14:15], v[22:23]
    s_waitcnt vmcnt(1)
    v_lshlrev_b32 v16, 16, v76
    v_and_b32 v17, s28, v76
    v_lshlrev_b32 v18, 16, v77
    v_and_b32 v19, s28, v77
    v_lshlrev_b32 v20, 16, v78
    v_and_b32 v21, s28, v78
    v_lshlrev_b32 v22, 16, v79
    v_and_b32 v23, s28, v79
    v_pk_add_f32 v[8:9], v[8:9], v[16:17]
    v_pk_add_f32 v[10:11], v[10:11], v[18:19]
    v_pk_add_f32 v[12:13], v[12:13], v[20:21]
    v_pk_add_f32 v[14:15], v[14:15], v[22:23]
    s_waitcnt vmcnt(0)
    v_lshlrev_b32 v16, 16, v80
    v_and_b32 v17, s28, v80
    v_lshlrev_b32 v18, 16, v81
    v_and_b32 v19, s28, v81
    v_lshlrev_b32 v20, 16, v82
    v_and_b32 v21, s28, v82
    v_lshlrev_b32 v22, 16, v83
    v_and_b32 v23, s28, v83
    v_pk_add_f32 v[8:9], v[8:9], v[16:17]
    v_pk_add_f32 v[10:11], v[10:11], v[18:19]
    v_pk_add_f32 v[12:13], v[12:13], v[20:21]
    v_pk_add_f32 v[14:15], v[14:15], v[22:23]
    ds_write_b128 v4, v[8:11]
    ds_write_b128 v4, v[12:15] offset:13376
    s_waitcnt lgkmcnt(0)
    s_barrier
    ds_read_b32 v16, v7 offset:0
    ds_read_b32 v17, v7 offset:1664
    ds_read_b32 v18, v7 offset:3328
    ds_read_b32 v19, v7 offset:4992
    ds_read_b32 v20, v7 offset:6656
    ds_read_b32 v21, v7 offset:8320
    ds_read_b32 v22, v7 offset:9984
    ds_read_b32 v23, v7 offset:11648
    s_waitcnt lgkmcnt(6)
    v_add_f32 v16, v16, v17
    s_waitcnt lgkmcnt(4)
    v_add_f32 v18, v18, v19
    s_waitcnt lgkmcnt(2)
    v_add_f32 v20, v20, v21
    v_add_f32 v16, v16, v18
    s_waitcnt lgkmcnt(0)
    v_add_f32 v22, v22, v23
    v_add_f32 v20, v20, v22
    v_add_f32 v16, v16, v20
    s_nop 1
    v_add_f32_dpp v16, v16, v16 row_ror:8 row_mask:0xf bank_mask:0xf
    v_mov_b32 v17, v16
    s_nop 1
    v_permlane16_swap_b32 v16, v17
    s_nop 1
    v_add_f32 v16, v16, v17
    v_mov_b32 v17, v16
    s_nop 1
    v_permlane32_swap_b32 v16, v17
    s_nop 1
    v_add_f32 v16, v16, v17
    s_mul_i32 s39, s38, 0x9e3779b1
    s_add_u32 s39, s39, 0x7f4a7c15
    v_mov_b32 v17, s39
    s_mov_b64 exec, 0xff
    buffer_store_dwordx2 v[16:17], v6, s[24:27], 0 offen sc1
    s_mov_b64 exec, -1
    s_cmp_ge_u32 s2, 12
    s_cbranch_scc1 L_bar2
    s_cmp_ge_u32 s3, 8
    s_cbranch_scc1 L_obar
    s_lshl_b32 s29, s2, 14
    s_lshl_b32 s30, s3, 11
    s_add_u32 s29, s29, s30
    s_mov_b32 s36, 100000
L_own:
    buffer_load_dwordx4 v[8:11], v88, s[24:27], s29 offen sc1
    buffer_load_dwordx4 v[12:15], v88, s[24:27], s29 offen offset:1024 sc1
    s_waitcnt vmcnt(0)
    v_xor_b32 v16, s39, v9
    v_xor_b32 v17, s39, v11
    v_xor_b32 v18, s39, v13
    v_xor_b32 v19, s39, v15
    v_or3_b32 v16, v16, v17, v18
    v_or_b32 v16, v16, v19
    v_cmp_ne_u32 vcc, 0, v16
    s_and_b64 exec, exec, vcc
    s_cbranch_scc0 L_own_ok
    s_sub_u32 s36, s36, 1
    s_cmp_lg_u32 s36, 0
    s_cbranch_scc1 L_own
L_own_ok:
    s_mov_b64 exec, -1
    v_add_f32 v8, v8, v12
    v_add_f32 v9, v10, v14
    s_nop 1
    v_add_f32_dpp v8, v8, v8 row_ror:4 row_mask:0xf bank_mask:0xf
    v_add_f32_dpp v9, v9, v9 row_ror:4 row_mask:0xf bank_mask:0xf
    s_nop 1
    v_add_f32_dpp v8, v8, v8 row_ror:8 row_mask:0xf bank_mask:0xf
    v_add_f32_dpp v9, v9, v9 row_ror:8 row_mask:0xf bank_mask:0xf
    v_mov_b32 v10, v8
    v_mov_b32 v11, v9
    s_nop 1
    v_permlane16_swap_b32 v8, v10
    v_permlane16_swap_b32 v9, v11
    s_nop 1
    v_add_f32 v8, v8, v10
    v_add_f32 v9, v9, v11
    v_mov_b32 v10, v8
    v_mov_b32 v11, v9
    s_nop 1
    v_permlane32_swap_b32 v8, v10
    v_permlane32_swap_b32 v9, v11
    s_nop 1
    v_add_f32 v8, v8, v10
    v_add_f32 v9, v9, v11
    v_lshrrev_b32 v10, 1, v88
    s_lshl_b32 s29, s3, 5
    v_add_u32 v10, s29, v10
    s_mov_b64 exec, 0xf
    ds_write_b64 v10, v[8:9] offset:27136
    s_mov_b64 exec, -1
    s_waitcnt lgkmcnt(0)
L_obar:
    s_barrier
L_bar2:
    s_barrier
    ds_read_b128 v[8:11], v5 offset:26752
    ds_read_b128 v[12:15], v5 offset:26768
    s_mov_b32 s15, s14
    s_waitcnt lgkmcnt(0)
    s_cmp_lg_u32 s37, 0
    s_cbranch_scc1 L_nxs
    v_lshlrev_b32 v16, 16, v84
    v_and_b32 v17, s28, v84
    v_lshlrev_b32 v18, 16, v85
    v_and_b32 v19, s28, v85
    v_lshlrev_b32 v20, 16, v86
    v_and_b32 v21, s28, v86
    v_lshlrev_b32 v22, 16, v87
    v_and_b32 v23, s28, v87
    v_pk_mul_f32 v[16:17], v[16:17], v[8:9]
    v_pk_mul_f32 v[18:19], v[18:19], v[10:11]
    v_pk_mul_f32 v[20:21], v[20:21], v[12:13]
    v_pk_mul_f32 v[22:23], v[22:23], v[14:15]
    v_cvt_pk_bf16_f32 v84, v16, v17
    v_cvt_pk_bf16_f32 v85, v18, v19
    v_cvt_pk_bf16_f32 v86, v20, v21
    v_cvt_pk_bf16_f32 v87, v22, v23
    s_add_u32 s29, s31, 0
    buffer_store_dwordx4 v[84:87], v1, s[20:23], s29 offen sc1
    v_lshlrev_b32 v88, 16, v96
    v_and_b32 v89, s28, v96
    v_lshlrev_b32 v90, 16, v97
    v_and_b32 v91, s28, v97
    v_lshlrev_b32 v92, 16, v98
    v_and_b32 v93, s28, v98
    v_lshlrev_b32 v94, 16, v99
    v_and_b32 v95, s28, v99
    v_pk_mul_f32 v[88:89], v[88:89], v[8:9]
    v_pk_mul_f32 v[90:91], v[90:91], v[10:11]
    v_pk_mul_f32 v[92:93], v[92:93], v[12:13]
    v_pk_mul_f32 v[94:95], v[94:95], v[14:15]
    v_cvt_pk_bf16_f32 v96, v88, v89
    v_cvt_pk_bf16_f32 v97, v90, v91
    v_cvt_pk_bf16_f32 v98, v92, v93
    v_cvt_pk_bf16_f32 v99, v94, v95
    s_add_u32 s29, s31, 12288
    buffer_store_dwordx4 v[96:99], v1, s[20:23], s29 offen sc1
L_nxs:
    v_lshlrev_b32 v16, 16, v24
    v_and_b32 v17, s28, v24
    v_lshlrev_b32 v18, 16, v25
    v_and_b32 v19, s28, v25
    v_lshlrev_b32 v20, 16, v26
    v_and_b32 v21, s28, v26
    v_lshlrev_b32 v22, 16, v27
    v_and_b32 v23, s28, v27
    v_pk_mul_f32 v[16:17], v[16:17], v[8:9]
    v_pk_mul_f32 v[18:19], v[18:19], v[10:11]
    v_pk_mul_f32 v[20:21], v[20:21], v[12:13]
    v_pk_mul_f32 v[22:23], v[22:23], v[14:15]
    v_cvt_pk_bf16_f32 v24, v16, v17
    v_cvt_pk_bf16_f32 v25, v18, v19
    v_cvt_pk_bf16_f32 v26, v20, v21
    v_cvt_pk_bf16_f32 v27, v22, v23
    buffer_store_dwordx4 v[24:27], v1, s[20:23], s15 offen sc1
    s_add_u32 s15, s15, 3145728
    v_lshlrev_b32 v88, 16, v28
    v_and_b32 v89, s28, v28
    v_lshlrev_b32 v90, 16, v29
    v_and_b32 v91, s28, v29
    v_lshlrev_b32 v92, 16, v30
    v_and_b32 v93, s28, v30
    v_lshlrev_b32 v94, 16, v31
    v_and_b32 v95, s28, v31
    v_pk_mul_f32 v[88:89], v[88:89], v[8:9]
    v_pk_mul_f32 v[90:91], v[90:91], v[10:11]
    v_pk_mul_f32 v[92:93], v[92:93], v[12:13]
    v_pk_mul_f32 v[94:95], v[94:95], v[14:15]
    v_cvt_pk_bf16_f32 v28, v88, v89
    v_cvt_pk_bf16_f32 v29, v90, v91
    v_cvt_pk_bf16_f32 v30, v92, v93
    v_cvt_pk_bf16_f32 v31, v94, v95
    buffer_store_dwordx4 v[28:31], v1, s[20:23], s15 offen sc1
    s_add_u32 s15, s15, 3145728
    v_lshlrev_b32 v16, 16, v32
    v_and_b32 v17, s28, v32
    v_lshlrev_b32 v18, 16, v33
    v_and_b32 v19, s28, v33
    v_lshlrev_b32 v20, 16, v34
    v_and_b32 v21, s28, v34
    v_lshlrev_b32 v22, 16, v35
    v_and_b32 v23, s28, v35
    v_pk_mul_f32 v[16:17], v[16:17], v[8:9]
    v_pk_mul_f32 v[18:19], v[18:19], v[10:11]
    v_pk_mul_f32 v[20:21], v[20:21], v[12:13]
    v_pk_mul_f32 v[22:23], v[22:23], v[14:15]
    v_cvt_pk_bf16_f32 v32, v16, v17
    v_cvt_pk_bf16_f32 v33, v18, v19
    v_cvt_pk_bf16_f32 v34, v20, v21
    v_cvt_pk_bf16_f32 v35, v22, v23
    buffer_store_dwordx4 v[32:35], v1, s[20:23], s15 offen sc1
    s_add_u32 s15, s15, 3145728
    v_lshlrev_b32 v88, 16, v36
    v_and_b32 v89, s28, v36
    v_lshlrev_b32 v90, 16, v37
    v_and_b32 v91, s28, v37
    v_lshlrev_b32 v92, 16, v38
    v_and_b32 v93, s28, v38
    v_lshlrev_b32 v94, 16, v39
    v_and_b32 v95, s28, v39
    v_pk_mul_f32 v[88:89], v[88:89], v[8:9]
    v_pk_mul_f32 v[90:91], v[90:91], v[10:11]
    v_pk_mul_f32 v[92:93], v[92:93], v[12:13]
    v_pk_mul_f32 v[94:95], v[94:95], v[14:15]
    v_cvt_pk_bf16_f32 v36, v88, v89
    v_cvt_pk_bf16_f32 v37, v90, v91
    v_cvt_pk_bf16_f32 v38, v92, v93
    v_cvt_pk_bf16_f32 v39, v94, v95
    buffer_store_dwordx4 v[36:39], v1, s[20:23], s15 offen sc1
    s_add_u32 s15, s15, 3145728
    v_lshlrev_b32 v16, 16, v40
    v_and_b32 v17, s28, v40
    v_lshlrev_b32 v18, 16, v41
    v_and_b32 v19, s28, v41
    v_lshlrev_b32 v20, 16, v42
    v_and_b32 v21, s28, v42
    v_lshlrev_b32 v22, 16, v43
    v_and_b32 v23, s28, v43
    v_pk_mul_f32 v[16:17], v[16:17], v[8:9]
    v_pk_mul_f32 v[18:19], v[18:19], v[10:11]
    v_pk_mul_f32 v[20:21], v[20:21], v[12:13]
    v_pk_mul_f32 v[22:23], v[22:23], v[14:15]
    v_cvt_pk_bf16_f32 v40, v16, v17
    v_cvt_pk_bf16_f32 v41, v18, v19
    v_cvt_pk_bf16_f32 v42, v20, v21
    v_cvt_pk_bf16_f32 v43, v22, v23
    buffer_store_dwordx4 v[40:43], v1, s[20:23], s15 offen sc1
    s_add_u32 s15, s15, 3145728
    v_lshlrev_b32 v88, 16, v44
    v_and_b32 v89, s28, v44
    v_lshlrev_b32 v90, 16, v45
    v_and_b32 v91, s28, v45
    v_lshlrev_b32 v92, 16, v46
    v_and_b32 v93, s28, v46
    v_lshlrev_b32 v94, 16, v47
    v_and_b32 v95, s28, v47
    v_pk_mul_f32 v[88:89], v[88:89], v[8:9]
    v_pk_mul_f32 v[90:91], v[90:91], v[10:11]
    v_pk_mul_f32 v[92:93], v[92:93], v[12:13]
    v_pk_mul_f32 v[94:95], v[94:95], v[14:15]
    v_cvt_pk_bf16_f32 v44, v88, v89
    v_cvt_pk_bf16_f32 v45, v90, v91
    v_cvt_pk_bf16_f32 v46, v92, v93
    v_cvt_pk_bf16_f32 v47, v94, v95
    buffer_store_dwordx4 v[44:47], v1, s[20:23], s15 offen sc1
    s_add_u32 s15, s15, 3145728
    v_lshlrev_b32 v16, 16, v48
    v_and_b32 v17, s28, v48
    v_lshlrev_b32 v18, 16, v49
    v_and_b32 v19, s28, v49
    v_lshlrev_b32 v20, 16, v50
    v_and_b32 v21, s28, v50
    v_lshlrev_b32 v22, 16, v51
    v_and_b32 v23, s28, v51
    v_pk_mul_f32 v[16:17], v[16:17], v[8:9]
    v_pk_mul_f32 v[18:19], v[18:19], v[10:11]
    v_pk_mul_f32 v[20:21], v[20:21], v[12:13]
    v_pk_mul_f32 v[22:23], v[22:23], v[14:15]
    v_cvt_pk_bf16_f32 v48, v16, v17
    v_cvt_pk_bf16_f32 v49, v18, v19
    v_cvt_pk_bf16_f32 v50, v20, v21
    v_cvt_pk_bf16_f32 v51, v22, v23
    buffer_store_dwordx4 v[48:51], v1, s[20:23], s15 offen sc1
    s_add_u32 s15, s15, 3145728
    v_lshlrev_b32 v88, 16, v52
    v_and_b32 v89, s28, v52
    v_lshlrev_b32 v90, 16, v53
    v_and_b32 v91, s28, v53
    v_lshlrev_b32 v92, 16, v54
    v_and_b32 v93, s28, v54
    v_lshlrev_b32 v94, 16, v55
    v_and_b32 v95, s28, v55
    v_pk_mul_f32 v[88:89], v[88:89], v[8:9]
    v_pk_mul_f32 v[90:91], v[90:91], v[10:11]
    v_pk_mul_f32 v[92:93], v[92:93], v[12:13]
    v_pk_mul_f32 v[94:95], v[94:95], v[14:15]
    v_cvt_pk_bf16_f32 v52, v88, v89
    v_cvt_pk_bf16_f32 v53, v90, v91
    v_cvt_pk_bf16_f32 v54, v92, v93
    v_cvt_pk_bf16_f32 v55, v94, v95
    buffer_store_dwordx4 v[52:55], v1, s[20:23], s15 offen sc1
    s_add_u32 s15, s15, 3145728
    v_lshlrev_b32 v16, 16, v56
    v_and_b32 v17, s28, v56
    v_lshlrev_b32 v18, 16, v57
    v_and_b32 v19, s28, v57
    v_lshlrev_b32 v20, 16, v58
    v_and_b32 v21, s28, v58
    v_lshlrev_b32 v22, 16, v59
    v_and_b32 v23, s28, v59
    v_pk_mul_f32 v[16:17], v[16:17], v[8:9]
    v_pk_mul_f32 v[18:19], v[18:19], v[10:11]
    v_pk_mul_f32 v[20:21], v[20:21], v[12:13]
    v_pk_mul_f32 v[22:23], v[22:23], v[14:15]
    v_cvt_pk_bf16_f32 v56, v16, v17
    v_cvt_pk_bf16_f32 v57, v18, v19
    v_cvt_pk_bf16_f32 v58, v20, v21
    v_cvt_pk_bf16_f32 v59, v22, v23
    buffer_store_dwordx4 v[56:59], v1, s[20:23], s15 offen sc1
    s_add_u32 s15, s15, 3145728
    v_lshlrev_b32 v88, 16, v60
    v_and_b32 v89, s28, v60
    v_lshlrev_b32 v90, 16, v61
    v_and_b32 v91, s28, v61
    v_lshlrev_b32 v92, 16, v62
    v_and_b32 v93, s28, v62
    v_lshlrev_b32 v94, 16, v63
    v_and_b32 v95, s28, v63
    v_pk_mul_f32 v[88:89], v[88:89], v[8:9]
    v_pk_mul_f32 v[90:91], v[90:91], v[10:11]
    v_pk_mul_f32 v[92:93], v[92:93], v[12:13]
    v_pk_mul_f32 v[94:95], v[94:95], v[14:15]
    v_cvt_pk_bf16_f32 v60, v88, v89
    v_cvt_pk_bf16_f32 v61, v90, v91
    v_cvt_pk_bf16_f32 v62, v92, v93
    v_cvt_pk_bf16_f32 v63, v94, v95
    buffer_store_dwordx4 v[60:63], v1, s[20:23], s15 offen sc1
    s_add_u32 s15, s15, 3145728
    v_lshlrev_b32 v16, 16, v64
    v_and_b32 v17, s28, v64
    v_lshlrev_b32 v18, 16, v65
    v_and_b32 v19, s28, v65
    v_lshlrev_b32 v20, 16, v66
    v_and_b32 v21, s28, v66
    v_lshlrev_b32 v22, 16, v67
    v_and_b32 v23, s28, v67
    v_pk_mul_f32 v[16:17], v[16:17], v[8:9]
    v_pk_mul_f32 v[18:19], v[18:19], v[10:11]
    v_pk_mul_f32 v[20:21], v[20:21], v[12:13]
    v_pk_mul_f32 v[22:23], v[22:23], v[14:15]
    v_cvt_pk_bf16_f32 v64, v16, v17
    v_cvt_pk_bf16_f32 v65, v18, v19
    v_cvt_pk_bf16_f32 v66, v20, v21
    v_cvt_pk_bf16_f32 v67, v22, v23
    buffer_store_dwordx4 v[64:67], v1, s[20:23], s15 offen sc1
    s_add_u32 s15, s15, 3145728
    v_lshlrev_b32 v88, 16, v68
    v_and_b32 v89, s28, v68
    v_lshlrev_b32 v90, 16, v69
    v_and_b32 v91, s28, v69
    v_lshlrev_b32 v92, 16, v70
    v_and_b32 v93, s28, v70
    v_lshlrev_b32 v94, 16, v71
    v_and_b32 v95, s28, v71
    v_pk_mul_f32 v[88:89], v[88:89], v[8:9]
    v_pk_mul_f32 v[90:91], v[90:91], v[10:11]
    v_pk_mul_f32 v[92:93], v[92:93], v[12:13]
    v_pk_mul_f32 v[94:95], v[94:95], v[14:15]
    v_cvt_pk_bf16_f32 v68, v88, v89
    v_cvt_pk_bf16_f32 v69, v90, v91
    v_cvt_pk_bf16_f32 v70, v92, v93
    v_cvt_pk_bf16_f32 v71, v94, v95
    buffer_store_dwordx4 v[68:71], v1, s[20:23], s15 offen sc1
    s_add_u32 s15, s15, 3145728
    v_lshlrev_b32 v16, 16, v72
    v_and_b32 v17, s28, v72
    v_lshlrev_b32 v18, 16, v73
    v_and_b32 v19, s28, v73
    v_lshlrev_b32 v20, 16, v74
    v_and_b32 v21, s28, v74
    v_lshlrev_b32 v22, 16, v75
    v_and_b32 v23, s28, v75
    v_pk_mul_f32 v[16:17], v[16:17], v[8:9]
    v_pk_mul_f32 v[18:19], v[18:19], v[10:11]
    v_pk_mul_f32 v[20:21], v[20:21], v[12:13]
    v_pk_mul_f32 v[22:23], v[22:23], v[14:15]
    v_cvt_pk_bf16_f32 v72, v16, v17
    v_cvt_pk_bf16_f32 v73, v18, v19
    v_cvt_pk_bf16_f32 v74, v20, v21
    v_cvt_pk_bf16_f32 v75, v22, v23
    buffer_store_dwordx4 v[72:75], v1, s[20:23], s15 offen sc1
    s_add_u32 s15, s15, 3145728
    v_lshlrev_b32 v88, 16, v76
    v_and_b32 v89, s28, v76
    v_lshlrev_b32 v90, 16, v77
    v_and_b32 v91, s28, v77
    v_lshlrev_b32 v92, 16, v78
    v_and_b32 v93, s28, v78
    v_lshlrev_b32 v94, 16, v79
    v_and_b32 v95, s28, v79
    v_pk_mul_f32 v[88:89], v[88:89], v[8:9]
    v_pk_mul_f32 v[90:91], v[90:91], v[10:11]
    v_pk_mul_f32 v[92:93], v[92:93], v[12:13]
    v_pk_mul_f32 v[94:95], v[94:95], v[14:15]
    v_cvt_pk_bf16_f32 v76, v88, v89
    v_cvt_pk_bf16_f32 v77, v90, v91
    v_cvt_pk_bf16_f32 v78, v92, v93
    v_cvt_pk_bf16_f32 v79, v94, v95
    buffer_store_dwordx4 v[76:79], v1, s[20:23], s15 offen sc1
    s_add_u32 s15, s15, 3145728
    v_lshlrev_b32 v16, 16, v80
    v_and_b32 v17, s28, v80
    v_lshlrev_b32 v18, 16, v81
    v_and_b32 v19, s28, v81
    v_lshlrev_b32 v20, 16, v82
    v_and_b32 v21, s28, v82
    v_lshlrev_b32 v22, 16, v83
    v_and_b32 v23, s28, v83
    v_pk_mul_f32 v[16:17], v[16:17], v[8:9]
    v_pk_mul_f32 v[18:19], v[18:19], v[10:11]
    v_pk_mul_f32 v[20:21], v[20:21], v[12:13]
    v_pk_mul_f32 v[22:23], v[22:23], v[14:15]
    v_cvt_pk_bf16_f32 v80, v16, v17
    v_cvt_pk_bf16_f32 v81, v18, v19
    v_cvt_pk_bf16_f32 v82, v20, v21
    v_cvt_pk_bf16_f32 v83, v22, v23
    buffer_store_dwordx4 v[80:83], v1, s[20:23], s15 offen sc1
    s_endpgm
L_ctrl:
    s_setprio 3
    s_mov_b32 s24, s12
    s_and_b32 s25, s13, 0xffff
    s_mov_b32 s26, 336128
    s_mov_b32 s27, 0x00020000
    s_load_dword s30, s[6:7], 0
    v_and_b32 v6, 63, v0
    v_lshlrev_b32 v1, 4, v6
    v_mov_b32 v2, 0
    s_waitcnt lgkmcnt(0)
    s_lshl_b32 s30, s30, 16
    s_mul_i32 s39, s38, 0x9e3779b1
    s_add_u32 s39, s39, 0x7f4a7c15
    s_barrier
    s_cmp_ge_u32 s2, 12
    s_cbranch_scc1 L_spoll
    s_barrier
    v_lshlrev_b32 v3, 2, v6
    ds_read_b32 v8, v3 offset:27136
    s_waitcnt lgkmcnt(0)
    s_nop 0
    v_add_f32_dpp v8, v8, v8 row_ror:8 row_mask:0xf bank_mask:0xf
    v_mov_b32 v9, v8
    s_nop 1
    v_permlane16_swap_b32 v8, v9
    s_nop 1
    v_add_f32 v8, v8, v9
    v_mov_b32 v9, v8
    s_nop 1
    v_permlane32_swap_b32 v8, v9
    s_nop 1
    v_add_f32 v8, v8, v9
    v_cvt_pk_bf16_f32 v8, v8, v8
    v_and_b32 v8, 0xffff0000, v8
    v_mul_f32 v8, 0x36800000, v8
    v_cvt_pk_bf16_f32 v8, v8, v8
    v_and_b32 v8, 0xffff0000, v8
    v_mul_f32 v8, s30, v8
    v_cvt_pk_bf16_f32 v8, v8, v8
    v_and_b32 v8, 0xffff0000, v8
    v_mul_f32 v8, 0xbfb8aa3b, v8
    v_exp_f32 v8, v8
    s_nop 0
    v_add_f32 v8, 1.0, v8
    v_rcp_f32 v8, v8
    s_nop 0
    v_cvt_pk_bf16_f32 v8, v8, v8
    v_and_b32 v8, 0xffff0000, v8
    v_mov_b32 v9, s39
    v_lshrrev_b32 v3, 3, v6
    v_mul_u32_u24 v3, 4352, v3
    v_and_b32 v4, 7, v6
    v_lshl_add_u32 v3, v4, 3, v3
    s_lshl_b32 s29, s2, 6
    s_add_u32 s29, s29, 196608
    buffer_store_dwordx2 v[8:9], v3, s[24:27], s29 offen sc1
    s_add_u32 s29, s29, 34816
    buffer_store_dwordx2 v[8:9], v3, s[24:27], s29 offen sc1
    s_add_u32 s29, s29, 34816
    buffer_store_dwordx2 v[8:9], v3, s[24:27], s29 offen sc1
    s_add_u32 s29, s29, 34816
    buffer_store_dwordx2 v[8:9], v3, s[24:27], s29 offen sc1
L_spoll:
    s_mov_b32 s36, 100000
    s_and_b32 s29, s2, 31
    s_mul_i32 s29, s29, 4352
    s_add_u32 s29, s29, 196608
    s_lshr_b32 s32, s2, 5
    s_lshl_b32 s32, s32, 2
    s_lshl_b64 exec, 15, s32
L_spa:
    buffer_load_dwordx4 v[64:67], v1, s[24:27], s29 offen sc1
    s_waitcnt vmcnt(0)
    v_xor_b32 v16, s39, v65
    v_xor_b32 v17, s39, v67
    v_or_b32 v16, v16, v17
    v_cmp_ne_u32 vcc, 0, v16
    s_cbranch_vccz L_spa_ok
    s_sub_u32 s36, s36, 1
    s_cmp_lg_u32 s36, 0
    s_cbranch_scc1 L_spa
L_spa_ok:
    s_mov_b32 s36, 100000
    s_mov_b32 exec_lo, -1
    s_mov_b32 exec_hi, 0xffff
L_sp:
    buffer_load_dwordx4 v[64:67], v1, s[24:27], s29 offen sc1
    s_waitcnt vmcnt(0)
    v_xor_b32 v16, s39, v65
    v_xor_b32 v17, s39, v67
    v_or_b32 v16, v16, v17
    v_cmp_ne_u32 vcc, 0, v16
    s_and_b64 exec, exec, vcc
    s_cbranch_scc0 L_sp_ok
    s_sub_u32 s36, s36, 1
    s_cmp_lg_u32 s36, 0
    s_cbranch_scc1 L_sp
L_sp_ok:
    s_mov_b32 exec_lo, -1
    s_mov_b32 exec_hi, 0xffff
    v_mov_b32 v8, v64
    v_mov_b32 v9, v66
    v_lshlrev_b32 v3, 3, v6
    ds_write_b64 v3, v[8:9] offset:26752
    s_mov_b64 exec, -1
    s_waitcnt lgkmcnt(0)
    s_barrier
    s_cmp_lg_u32 s2, 0
    s_cbranch_scc1 L_noep
    s_add_u32 s38, s38, 1
    v_mov_b32 v8, s38
    s_mov_b32 s29, 335872
    s_mov_b64 exec, 1
    buffer_store_dword v8, v2, s[24:27], s29 offen sc1
    s_mov_b64 exec, -1
L_noep:
    s_waitcnt vmcnt(0)
L_end:
    s_endpgm
.section .rodata,"a"
.p2align 6
.amdhsa_kernel standalone__channel_attn_eca__vision_kernel
  .amdhsa_next_free_vgpr 100
  .amdhsa_next_free_sgpr 48
  .amdhsa_accum_offset 100
  .amdhsa_group_segment_fixed_size 0
  .amdhsa_kernarg_size 40
  .amdhsa_user_sgpr_count 2
  .amdhsa_user_sgpr_kernarg_segment_ptr 1
  .amdhsa_system_sgpr_workgroup_id_x 1
  .amdhsa_float_denorm_mode_32 3
.end_amdhsa_kernel
```
